```python
import torch

def _softmax(x, axis=-1):
    return torch.softmax(x, dim=axis)
def _gelu(x):
    return torch.nn.functional.gelu(x, approximate="tanh")
def _silu(x):
    return torch.nn.functional.silu(x)
def _sigmoid(x):
    return torch.sigmoid(x)
def _layernorm(x, axis=-1, eps=1e-5):
    m = x.mean(dim=axis, keepdim=True)
    v = x.var(dim=axis, keepdim=True, unbiased=False)
    return (x - m) / torch.sqrt(v + eps)
def _scatter_add(tgt, idx, src, axis=0):
    return tgt.clone().index_add_(axis, idx, src)
def _segment_sum(src, seg, n):
    out = torch.zeros((n,) + src.shape[1:], dtype=src.dtype)
    return out.index_add_(0, seg, src)
def _pad(x, pw):
    flat = tuple(v for pair in reversed(pw) for v in pair)
    return torch.nn.functional.pad(x, flat)

kernel_name = 'concat_heads__sliding_block_cached__sliding_block_cached__decode'

def setup_inputs():

    _w = (lambda a: (lambda t: t.to(torch.bfloat16) if t.is_floating_point() else t)(torch.as_tensor(a)))
    def _A_setup():
        B, Sq, D = 2, 1, 512
        Hq, Hkv, Sk, Dh = 32, 8, 8192, 128
        assert Hq % Hkv == 0, (Hq, Hkv)
        return {
            "x": _w((lambda *s: torch.randn(*s, dtype=torch.bfloat16) * 0.8)(B, Sq, D)),
            "k_cache": _w((lambda *s: torch.randn(*s, dtype=torch.bfloat16) * 0.8)(B, Hkv, Sk, Dh)),
            "v_cache": _w((lambda *s: torch.randn(*s, dtype=torch.bfloat16) * 0.05)(B, Hkv, Sk, Dh)),
            "wq": _w((lambda *s: torch.randn(*s, dtype=torch.bfloat16) * 0.8)(D, Hq * Dh) * (D ** -0.5)),
            "wo": _w((lambda *s: torch.randn(*s, dtype=torch.bfloat16) * 0.05)(Hq * Dh, D) * ((Hq * Dh) ** -0.5)),
        }
    _A_in = _A_setup()

    def _B_setup():
        B, Sq, D = 2, 1, 512
        Hq, Hkv, Sk, Dh = 32, 8, 8192, 128
        assert Hq % Hkv == 0, (Hq, Hkv)
        return {
            "x": _w((lambda *s: torch.randn(*s, dtype=torch.bfloat16) * 0.8)(B, Sq, D)),
            "k_cache": _w((lambda *s: torch.randn(*s, dtype=torch.bfloat16) * 0.8)(B, Hkv, Sk, Dh)),
            "v_cache": _w((lambda *s: torch.randn(*s, dtype=torch.bfloat16) * 0.05)(B, Hkv, Sk, Dh)),
            "wq": _w((lambda *s: torch.randn(*s, dtype=torch.bfloat16) * 0.8)(D, Hq * Dh) * (D ** -0.5)),
            "wo": _w((lambda *s: torch.randn(*s, dtype=torch.bfloat16) * 0.05)(Hq * Dh, D) * ((Hq * Dh) ** -0.5)),
        }
    _B_in = _B_setup()

    return {
        "A_x": _A_in["x"],
        "A_k_cache": _A_in["k_cache"],
        "A_v_cache": _A_in["v_cache"],
        "A_wq": _A_in["wq"],
        "A_wo": _A_in["wo"],
        "B_x": _B_in["x"],
        "B_k_cache": _B_in["k_cache"],
        "B_v_cache": _B_in["v_cache"],
        "B_wq": _B_in["wq"],
        "B_wo": _B_in["wo"],
    }

def reference(A_x, A_k_cache, A_v_cache, A_wq, A_wo, B_x, B_k_cache, B_v_cache, B_wq, B_wo):
    def _A_ref(x, k_cache, v_cache, wq, wo):
        B, Sq, D = x.shape
        Hq, Dh = 32, 128
        Hkv, Sk = k_cache.shape[1], k_cache.shape[2]
        W = min(4096, max(256, Sk // 4))
        rep = Hq // Hkv
        q = (lambda x, *d: x.permute(*d))((x @ wq).reshape(B, Sq, Hq, Dh), 0, 2, 1, 3)
        k = (lambda x, n, axis: torch.repeat_interleave(x, n, dim=axis))(k_cache[:, :, Sk - W:, :], rep, axis=1)
        v = (lambda x, n, axis: torch.repeat_interleave(x, n, dim=axis))(v_cache[:, :, Sk - W:, :], rep, axis=1)
        scores = torch.einsum("bhqd,bhkd->bhqk", q, k) * (Dh ** -0.5)
        p = _softmax(scores, axis=-1)
        o = torch.einsum("bhqk,bhkd->bhqd", p, v)
        return (lambda x, *d: x.permute(*d))(o, 0, 2, 1, 3).reshape(B, Sq, Hq * Dh) @ wo

    def _B_ref(x, k_cache, v_cache, wq, wo):
        B, Sq, D = x.shape
        Hq, Dh = 32, 128
        Hkv, Sk = k_cache.shape[1], k_cache.shape[2]
        W = min(4096, max(256, Sk // 4))
        rep = Hq // Hkv
        q = (lambda x, *d: x.permute(*d))((x @ wq).reshape(B, Sq, Hq, Dh), 0, 2, 1, 3)
        k = (lambda x, n, axis: torch.repeat_interleave(x, n, dim=axis))(k_cache[:, :, Sk - W:, :], rep, axis=1)
        v = (lambda x, n, axis: torch.repeat_interleave(x, n, dim=axis))(v_cache[:, :, Sk - W:, :], rep, axis=1)
        scores = torch.einsum("bhqd,bhkd->bhqk", q, k) * (Dh ** -0.5)
        p = _softmax(scores, axis=-1)
        o = torch.einsum("bhqk,bhkd->bhqd", p, v)
        return (lambda x, *d: x.permute(*d))(o, 0, 2, 1, 3).reshape(B, Sq, Hq * Dh) @ wo

    a = _A_ref(A_x, A_k_cache, A_v_cache, A_wq, A_wo)
    b = _B_ref(B_x, B_k_cache, B_v_cache, B_wq, B_wo)
    return torch.concatenate([a, b], axis=-1)
```

```asm
; @launch grid=(256,1,1) block=(512,1,1) lds=36864
.amdgcn_target "amdgcn-amd-amdhsa--gfx950"
.text
.globl concat_heads__sliding_block_cached__sliding_block_cached__decode_kernel
.p2align 8
.type concat_heads__sliding_block_cached__sliding_block_cached__decode_kernel,@function
concat_heads__sliding_block_cached__sliding_block_cached__decode_kernel:
    s_cmp_ge_u32 s2, 0x100
    s_cbranch_scc1 L_end
    s_load_dwordx16 s[8:23], s[0:1], 0
    s_load_dwordx8 s[24:31], s[0:1], 64
    s_load_dwordx2 s[32:33], s[0:1], 96
    v_lshrrev_b32 v5, 6, v0
    v_and_b32 v0, 63, v0
    s_lshr_b32 s4, s2, 7
    v_readfirstlane_b32 s3, v5
    s_and_b32 s5, s2, 7
    s_bfe_u32 s6, s2, 0x40003
    s_lshr_b32 s36, s6, 3
    s_and_b32 s37, s6, 7
    s_lshr_b32 s38, s6, 1
    s_and_b32 s39, s6, 1
    v_lshrrev_b32 v10, 3, v0
    v_and_b32 v11, 7, v0
    v_lshlrev_b32 v5, 15, v10
    v_lshl_add_u32 v5, v11, 4, v5
    v_lshlrev_b32 v6, 3, v10
    v_bfe_u32 v8, v0, 2, 2
    v_lshlrev_b32 v8, 8, v8
    v_lshrrev_b32 v10, 4, v0
    v_lshl_add_u32 v8, v10, 6, v8
    v_and_b32 v11, 3, v0
    v_lshl_add_u32 v8, v11, 4, v8
    v_lshlrev_b32 v9, 4, v0
    s_lshl_b32 s41, s39, 8
    s_lshl_b32 s42, s3, 5
    s_add_u32 s41, s41, s42
    s_lshl_b32 s42, s41, 13
    s_lshl_b32 s43, s5, 10
    s_add_u32 s42, s42, s43
    s_lshl_b32 s43, s38, 7
    s_add_u32 s42, s42, s43
    s_lshl_b32 s41, s41, 1
    s_lshl_b32 s40, s36, 3
    s_add_u32 s40, s40, s5
    s_lshl_b32 s40, s40, 21
    s_lshl_b32 s43, s37, 16
    s_add_u32 s40, s40, s43
    s_lshl_b32 s43, s3, 13
    s_add_u32 s40, s40, s43
    s_add_u32 s40, s40, 1576960
    s_lshl_b32 s60, s4, 3
    s_add_u32 s60, s60, s5
    s_cmp_eq_u32 s4, 0
    s_waitcnt lgkmcnt(0)
    s_cselect_b64 s[14:15], s[14:15], s[24:25]
    s_cselect_b64 s[8:9], s[8:9], s[18:19]
    s_cselect_b64 s[10:11], s[10:11], s[20:21]
    s_cselect_b64 s[12:13], s[12:13], s[22:23]
    s_cselect_b64 s[16:17], s[16:17], s[26:27]
    s_add_u32 s8, s8, s41
    s_addc_u32 s9, s9, 0
    s_add_u32 s14, s14, s42
    s_addc_u32 s15, s15, 0
    global_load_dwordx2 v[96:97], v6, s[8:9]
    global_load_dwordx2 v[98:99], v6, s[8:9] offset:1024
    global_load_dwordx4 v[16:19], v5, s[14:15] nt
    s_add_u32 s14, s14, 8192
    s_addc_u32 s15, s15, 0
    global_load_dwordx4 v[20:23], v5, s[14:15] nt
    s_add_u32 s14, s14, 8192
    s_addc_u32 s15, s15, 0
    global_load_dwordx4 v[24:27], v5, s[14:15] nt
    s_add_u32 s14, s14, 8192
    s_addc_u32 s15, s15, 0
    global_load_dwordx4 v[28:31], v5, s[14:15] nt
    s_add_u32 s10, s10, s40
    s_addc_u32 s11, s11, 0
    v_mov_b32 v10, 36160
    v_mov_b32 v11, 0
    ds_write_b32 v10, v11
    s_waitcnt lgkmcnt(0)
    s_barrier
    s_add_u32 s12, s12, s40
    s_addc_u32 s13, s13, 0
    s_lshl_b32 s43, s4, 8
    s_load_dword s34, s[32:33], s43
    s_getreg_b32 s61, hwreg(HW_REG_XCC_ID)
    s_cmp_eq_u32 s3, 4
    s_cbranch_scc0 L_nt4
    v_mov_b32 v10, 0
    global_load_dword v172, v10, s[10:11]
L_nt4:
    s_cmp_eq_u32 s3, 5
    s_cbranch_scc0 L_nt5
    v_mov_b32 v10, 0
    global_load_dword v172, v10, s[12:13]
L_nt5:
    s_cmp_eq_u32 s3, 6
    s_cbranch_scc0 L_nt6
    s_lshl_b32 s41, s5, 19
    v_mov_b32 v10, s41
    global_load_dword v172, v10, s[16:17]
L_nt6:
    s_cmp_eq_u32 s3, 7
    s_cbranch_scc0 L_notouch
    v_mov_b32 v10, 0
    v_mov_b32 v11, 2621440
    global_load_dword v172, v10, s[28:29]
    global_load_dword v173, v11, s[32:33]
L_notouch:
    v_and_b32 v10, 1, v0
    v_lshlrev_b32 v10, 4, v10
    v_mov_b32 v11, 0xffff
    v_lshlrev_b32 v11, v10, v11
    v_bfe_u32 v10, v0, 1, 2
    v_cmp_eq_u32 vcc, 0, v10
    s_nop 1
    v_cndmask_b32 v1, 0, v11, vcc
    v_cmp_eq_u32 vcc, 1, v10
    s_nop 1
    v_cndmask_b32 v2, 0, v11, vcc
    v_cmp_eq_u32 vcc, 2, v10
    s_nop 1
    v_cndmask_b32 v3, 0, v11, vcc
    v_cmp_eq_u32 vcc, 3, v10
    s_nop 1
    v_cndmask_b32 v4, 0, v11, vcc
    v_and_b32 v10, 2, v0
    v_cmp_eq_u32 vcc, 0, v10
    s_nop 1
    v_cndmask_b32 v166, 0, v11, vcc
    v_xor_b32 v167, v166, v11
    v_and_b32 v10, 3, v0
    v_cmp_eq_u32 s[48:49], 1, v10
    v_cmp_eq_u32 s[50:51], 2, v10
    v_cmp_eq_u32 s[52:53], 3, v10
    s_mov_b32 s57, 0x01000100
    s_mov_b32 s58, 0x03020302
    s_mov_b32 s59, 0x3e0293ee
    s_mov_b32 s98, 0xaaaaaaaa
    s_mov_b32 s99, 0xaaaaaaaa
    s_lshl_b32 s41, s5, 19
    s_lshl_b32 s42, s38, 16
    s_add_u32 s41, s41, s42
    s_lshl_b32 s42, s3, 13
    s_add_u32 s41, s41, s42
    s_lshl_b32 s42, s39, 9
    s_add_u32 s41, s41, s42
    s_add_u32 s41, s41, 4096
    s_add_u32 s16, s16, s41
    s_addc_u32 s17, s17, 0
    v_lshrrev_b32 v10, 4, v0
    v_lshlrev_b32 v7, 10, v10
    v_and_b32 v11, 15, v0
    v_lshl_add_u32 v7, v11, 4, v7
    v_bfe_u32 v11, v0, 3, 1
    v_lshl_add_u32 v169, v11, 5, v10
    v_lshlrev_b32 v169, 2, v169
    s_lshl_b32 s41, s60, 14
    s_lshl_b32 s42, s36, 13
    s_add_u32 s41, s41, s42
    s_lshl_b32 s42, s3, 10
    s_add_u32 s41, s41, s42
    s_add_u32 s41, s41, 4096
    s_add_u32 s96, s32, s41
    s_addc_u32 s97, s33, 0
    s_waitcnt vmcnt(3)
    global_load_dwordx4 v[32:35], v8, s[10:11] offset:-4096 nt
    global_load_dwordx4 v[36:39], v8, s[10:11] offset:-3072 nt
    global_load_dwordx4 v[40:43], v8, s[10:11] offset:-2048 nt
    v_perm_b32 v10, v96, v96, s57
    v_and_b32 v100, v10, v1
    v_and_b32 v101, v10, v2
    v_and_b32 v102, v10, v3
    v_and_b32 v103, v10, v4
    v_perm_b32 v11, v98, v98, s57
    v_and_b32 v104, v11, v1
    v_and_b32 v105, v11, v2
    v_and_b32 v106, v11, v3
    v_and_b32 v107, v11, v4
    v_mfma_f32_16x16x32_bf16 v[108:111], v[16:19], v[100:103], 0
    s_nop 0
    v_mfma_f32_16x16x32_bf16 v[112:115], v[16:19], v[104:107], 0
    s_waitcnt vmcnt(5)
    global_load_dwordx4 v[44:47], v8, s[10:11] offset:-1024 nt
    v_perm_b32 v10, v96, v96, s58
    v_and_b32 v100, v10, v1
    v_and_b32 v101, v10, v2
    v_and_b32 v102, v10, v3
    v_and_b32 v103, v10, v4
    v_perm_b32 v11, v98, v98, s58
    v_and_b32 v104, v11, v1
    v_and_b32 v105, v11, v2
    v_and_b32 v106, v11, v3
    v_and_b32 v107, v11, v4
    v_mfma_f32_16x16x32_bf16 v[108:111], v[20:23], v[100:103], v[108:111]
    s_nop 0
    v_mfma_f32_16x16x32_bf16 v[112:115], v[20:23], v[104:107], v[112:115]
    s_waitcnt vmcnt(5)
    global_load_dwordx4 v[48:51], v8, s[10:11] offset:0 nt
    v_perm_b32 v10, v97, v97, s57
    v_and_b32 v100, v10, v1
    v_and_b32 v101, v10, v2
    v_and_b32 v102, v10, v3
    v_and_b32 v103, v10, v4
    v_perm_b32 v11, v99, v99, s57
    v_and_b32 v104, v11, v1
    v_and_b32 v105, v11, v2
    v_and_b32 v106, v11, v3
    v_and_b32 v107, v11, v4
    v_mfma_f32_16x16x32_bf16 v[108:111], v[24:27], v[100:103], v[108:111]
    s_nop 0
    v_mfma_f32_16x16x32_bf16 v[112:115], v[24:27], v[104:107], v[112:115]
    s_waitcnt vmcnt(5)
    global_load_dwordx4 v[52:55], v8, s[10:11] offset:1024 nt
    v_perm_b32 v10, v97, v97, s58
    v_and_b32 v100, v10, v1
    v_and_b32 v101, v10, v2
    v_and_b32 v102, v10, v3
    v_and_b32 v103, v10, v4
    v_perm_b32 v11, v99, v99, s58
    v_and_b32 v104, v11, v1
    v_and_b32 v105, v11, v2
    v_and_b32 v106, v11, v3
    v_and_b32 v107, v11, v4
    v_mfma_f32_16x16x32_bf16 v[108:111], v[28:31], v[100:103], v[108:111]
    s_nop 0
    v_mfma_f32_16x16x32_bf16 v[112:115], v[28:31], v[104:107], v[112:115]
    s_lshl_b32 s41, s3, 11
    v_lshlrev_b32 v10, 2, v0
    v_add_u32 v10, s41, v10
    s_nop 6
    ds_write2st64_b32 v10, v108, v109 offset0:0 offset1:1
    ds_write2st64_b32 v10, v110, v111 offset0:2 offset1:3
    ds_write2st64_b32 v10, v112, v113 offset0:4 offset1:5
    ds_write2st64_b32 v10, v114, v115 offset0:6 offset1:7
    s_waitcnt lgkmcnt(0)
    s_add_u32 s35, s34, 0x9e3779b9
    v_mov_b32 v14, 36160
    v_mov_b32 v15, 1
    s_mov_b64 exec, 1
    ds_add_u32 v14, v15
    s_mov_b64 exec, -1
    s_cmp_eq_u32 s3, 7
    s_cbranch_scc0 L_noqpub
L_cw:
    ds_read_b32 v15, v14
    s_waitcnt lgkmcnt(0)
    v_readfirstlane_b32 s63, v15
    s_cmp_lt_u32 s63, 8
    s_cbranch_scc1 L_cw
    v_lshrrev_b32 v10, 5, v0
    v_lshlrev_b32 v10, 10, v10
    v_bfe_u32 v11, v0, 2, 2
    v_lshl_add_u32 v10, v11, 8, v10
    v_bfe_u32 v11, v0, 4, 1
    v_lshl_add_u32 v10, v11, 6, v10
    v_and_b32 v11, 3, v0
    v_lshl_add_u32 v10, v11, 3, v10
    ds_read_b64 v[124:125], v10 offset:0
    ds_read_b64 v[126:127], v10 offset:160
    ds_read_b64 v[128:129], v10 offset:2048
    ds_read_b64 v[130:131], v10 offset:2208
    ds_read_b64 v[132:133], v10 offset:4096
    ds_read_b64 v[134:135], v10 offset:4256
    ds_read_b64 v[136:137], v10 offset:6144
    ds_read_b64 v[138:139], v10 offset:6304
    ds_read_b64 v[140:141], v10 offset:8192
    ds_read_b64 v[142:143], v10 offset:8352
    ds_read_b64 v[144:145], v10 offset:10240
    ds_read_b64 v[146:147], v10 offset:10400
    ds_read_b64 v[148:149], v10 offset:12288
    ds_read_b64 v[150:151], v10 offset:12448
    ds_read_b64 v[152:153], v10 offset:14336
    ds_read_b64 v[154:155], v10 offset:14496
    s_lshl_b32 s41, s60, 14
    s_lshl_b32 s42, s38, 10
    s_add_u32 s41, s41, s42
    s_lshl_b32 s42, s39, 9
    s_add_u32 s41, s41, s42
    s_add_u32 s41, s41, 4096
    s_add_u32 s44, s32, s41
    s_addc_u32 s45, s33, 0
    v_lshrrev_b32 v11, 5, v0
    v_lshlrev_b32 v11, 13, v11
    v_and_b32 v12, 31, v0
    v_lshl_add_u32 v11, v12, 4, v11
    v_mov_b32 v14, s61
    v_mov_b32 v15, s35
    s_waitcnt lgkmcnt(0)
    v_add_f32 v124, v124, v126
    v_add_f32 v125, v125, v127
    v_add_f32 v128, v128, v130
    v_add_f32 v129, v129, v131
    v_add_f32 v132, v132, v134
    v_add_f32 v133, v133, v135
    v_add_f32 v136, v136, v138
    v_add_f32 v137, v137, v139
    v_add_f32 v140, v140, v142
    v_add_f32 v141, v141, v143
    v_add_f32 v144, v144, v146
    v_add_f32 v145, v145, v147
    v_add_f32 v148, v148, v150
    v_add_f32 v149, v149, v151
    v_add_f32 v152, v152, v154
    v_add_f32 v153, v153, v155
    v_add_f32 v124, v124, v128
    v_add_f32 v125, v125, v129
    v_add_f32 v132, v132, v136
    v_add_f32 v133, v133, v137
    v_add_f32 v140, v140, v144
    v_add_f32 v141, v141, v145
    v_add_f32 v148, v148, v152
    v_add_f32 v149, v149, v153
    v_add_f32 v124, v124, v132
    v_add_f32 v125, v125, v133
    v_add_f32 v140, v140, v148
    v_add_f32 v141, v141, v149
    v_add_f32 v12, v124, v140
    v_add_f32 v13, v125, v141
    global_store_dwordx4 v11, v[12:15], s[44:45]
    s_add_u32 s44, s44, 262144
    s_addc_u32 s45, s45, 0
    global_store_dwordx4 v11, v[12:15], s[44:45] sc1
    s_waitcnt vmcnt(7)
    global_load_dwordx4 v[56:59], v8, s[10:11] offset:2048 nt
    s_waitcnt vmcnt(7)
    global_load_dwordx4 v[60:63], v8, s[10:11] offset:3072 nt
    s_waitcnt vmcnt(7)
    global_load_dwordx4 v[64:67], v9, s[12:13] offset:-4096 nt
    s_waitcnt vmcnt(7)
    global_load_dwordx4 v[116:119], v9, s[96:97] sc1
    s_waitcnt vmcnt(7)
    global_load_dwordx4 v[68:71], v9, s[12:13] offset:-3072 nt
    s_waitcnt vmcnt(7)
    global_load_dwordx4 v[72:75], v9, s[12:13] offset:-2048 nt
    s_waitcnt vmcnt(5)
    global_load_dwordx4 v[76:79], v9, s[12:13] offset:-1024 nt
    s_waitcnt vmcnt(5)
    global_load_dwordx4 v[80:83], v9, s[12:13] offset:0 nt
    s_waitcnt vmcnt(4)
    s_branch L_qchk
L_noqpub:
    s_waitcnt vmcnt(5)
    global_load_dwordx4 v[56:59], v8, s[10:11] offset:2048 nt
    s_waitcnt vmcnt(5)
    global_load_dwordx4 v[60:63], v8, s[10:11] offset:3072 nt
    s_waitcnt vmcnt(5)
    global_load_dwordx4 v[64:67], v9, s[12:13] offset:-4096 nt
    s_waitcnt vmcnt(5)
    global_load_dwordx4 v[116:119], v9, s[96:97] sc1
    s_waitcnt vmcnt(5)
    global_load_dwordx4 v[68:71], v9, s[12:13] offset:-3072 nt
    s_waitcnt vmcnt(5)
    global_load_dwordx4 v[72:75], v9, s[12:13] offset:-2048 nt
    s_waitcnt vmcnt(5)
    global_load_dwordx4 v[76:79], v9, s[12:13] offset:-1024 nt
    s_waitcnt vmcnt(5)
    global_load_dwordx4 v[80:83], v9, s[12:13] offset:0 nt
    s_waitcnt vmcnt(4)
L_qchk:
    s_mov_b32 s56, 200000
    v_cmp_eq_u32 vcc, s35, v119
    s_cmp_eq_u64 vcc, exec
    s_cbranch_scc1 L_qok
    s_not_b64 exec, vcc
    global_load_dwordx4 v[116:119], v9, s[96:97] sc1
    s_mov_b64 exec, -1
    global_load_dwordx4 v[84:87], v9, s[12:13] offset:1024 nt
    global_load_dwordx4 v[88:91], v9, s[12:13] offset:2048 nt
    s_waitcnt vmcnt(2)
    v_cmp_eq_u32 vcc, s35, v119
    s_cmp_eq_u64 vcc, exec
    s_cbranch_scc1 L_qafter
    s_not_b64 exec, vcc
    global_load_dwordx4 v[116:119], v9, s[96:97] sc1
    s_mov_b64 exec, -1
    s_waitcnt vmcnt(0)
    s_add_u32 s96, s96, 262144
    s_addc_u32 s97, s97, 0
L_qre:
    v_cmp_eq_u32 vcc, s35, v119
    s_cmp_eq_u64 vcc, exec
    s_cbranch_scc1 L_qafter
    s_sub_u32 s56, s56, 1
    s_cmp_eq_u32 s56, 0
    s_cbranch_scc1 L_qafter
    s_not_b64 exec, vcc
    global_load_dwordx4 v[116:119], v9, s[96:97] sc1
    s_mov_b64 exec, -1
    s_waitcnt vmcnt(0)
    s_branch L_qre
L_qok:
    global_load_dwordx4 v[84:87], v9, s[12:13] offset:1024 nt
    global_load_dwordx4 v[88:91], v9, s[12:13] offset:2048 nt
L_qafter:
    v_cmp_eq_u32 vcc, s61, v118
    v_mov_b32 v10, v116
    v_mov_b32 v11, v117
    s_cmp_eq_u64 vcc, exec
    s_cselect_b32 s42, 1, 0
    v_permlane32_swap_b32 v116, v10
    v_permlane32_swap_b32 v117, v11
    v_mov_b32 v13, s42
    v_add_f32 v116, v116, v10
    v_add_f32 v117, v117, v11
    v_and_b32 v12, 31, v0
    v_cvt_pk_bf16_f32 v11, v116, v117
    s_lshl_b32 s41, s3, 7
    v_lshlrev_b32 v12, 2, v12
    v_add_u32 v12, s41, v12
    ds_write_b32 v12, v11 offset:34816
    s_lshl_b32 s41, s3, 2
    v_mov_b32 v14, s41
    ds_write_b32 v14, v13 offset:36096
    s_waitcnt lgkmcnt(0)
    s_barrier
    v_add_u32 v10, 34816, v8
    ds_read_b128 v[120:123], v10
    v_mov_b32 v10, 0
    ds_read_b128 v[156:159], v10 offset:36096
    ds_read_b128 v[160:163], v10 offset:36112
    s_waitcnt vmcnt(5)
    global_load_dwordx4 v[92:95], v9, s[12:13] offset:3072 nt
    s_waitcnt lgkmcnt(0)
    v_mfma_f32_16x16x32_bf16 v[124:127], v[32:35], v[120:123], 0
    v_mfma_f32_16x16x32_bf16 v[128:131], v[36:39], v[120:123], 0
    v_mfma_f32_16x16x32_bf16 v[132:135], v[40:43], v[120:123], 0
    v_mfma_f32_16x16x32_bf16 v[136:139], v[44:47], v[120:123], 0
    v_mfma_f32_16x16x32_bf16 v[140:143], v[48:51], v[120:123], 0
    v_mfma_f32_16x16x32_bf16 v[144:147], v[52:55], v[120:123], 0
    v_mfma_f32_16x16x32_bf16 v[148:151], v[56:59], v[120:123], 0
    v_mfma_f32_16x16x32_bf16 v[152:155], v[60:63], v[120:123], 0
    v_and_b32 v156, v156, v157
    v_and_b32 v158, v158, v159
    v_and_b32 v160, v160, v161
    v_and_b32 v162, v162, v163
    v_and_b32 v156, v156, v158
    v_and_b32 v160, v160, v162
    v_and_b32 v156, v156, v160
    s_nop 1
    v_readfirstlane_b32 s62, v156
    s_nop 4
    v_mov_b32_dpp v156, v124 quad_perm:[0,0,0,0] row_mask:0xf bank_mask:0xf
    v_mov_b32_dpp v157, v128 quad_perm:[0,0,0,0] row_mask:0xf bank_mask:0xf
    v_mov_b32_dpp v158, v132 quad_perm:[0,0,0,0] row_mask:0xf bank_mask:0xf
    v_mov_b32_dpp v159, v136 quad_perm:[0,0,0,0] row_mask:0xf bank_mask:0xf
    v_add_f32_dpp v156, v125, v156 quad_perm:[1,1,1,1] row_mask:0xf bank_mask:0xf
    v_add_f32_dpp v157, v129, v157 quad_perm:[1,1,1,1] row_mask:0xf bank_mask:0xf
    v_add_f32_dpp v158, v133, v158 quad_perm:[1,1,1,1] row_mask:0xf bank_mask:0xf
    v_add_f32_dpp v159, v137, v159 quad_perm:[1,1,1,1] row_mask:0xf bank_mask:0xf
    v_add_f32_dpp v156, v126, v156 quad_perm:[2,2,2,2] row_mask:0xf bank_mask:0xf
    v_add_f32_dpp v157, v130, v157 quad_perm:[2,2,2,2] row_mask:0xf bank_mask:0xf
    v_add_f32_dpp v158, v134, v158 quad_perm:[2,2,2,2] row_mask:0xf bank_mask:0xf
    v_add_f32_dpp v159, v138, v159 quad_perm:[2,2,2,2] row_mask:0xf bank_mask:0xf
    v_add_f32_dpp v156, v127, v156 quad_perm:[3,3,3,3] row_mask:0xf bank_mask:0xf
    v_add_f32_dpp v157, v131, v157 quad_perm:[3,3,3,3] row_mask:0xf bank_mask:0xf
    v_add_f32_dpp v158, v135, v158 quad_perm:[3,3,3,3] row_mask:0xf bank_mask:0xf
    v_add_f32_dpp v159, v139, v159 quad_perm:[3,3,3,3] row_mask:0xf bank_mask:0xf
    v_mov_b32_dpp v160, v140 quad_perm:[0,0,0,0] row_mask:0xf bank_mask:0xf
    v_mov_b32_dpp v161, v144 quad_perm:[0,0,0,0] row_mask:0xf bank_mask:0xf
    v_mov_b32_dpp v162, v148 quad_perm:[0,0,0,0] row_mask:0xf bank_mask:0xf
    v_mov_b32_dpp v163, v152 quad_perm:[0,0,0,0] row_mask:0xf bank_mask:0xf
    v_add_f32_dpp v160, v141, v160 quad_perm:[1,1,1,1] row_mask:0xf bank_mask:0xf
    v_add_f32_dpp v161, v145, v161 quad_perm:[1,1,1,1] row_mask:0xf bank_mask:0xf
    v_add_f32_dpp v162, v149, v162 quad_perm:[1,1,1,1] row_mask:0xf bank_mask:0xf
    v_add_f32_dpp v163, v153, v163 quad_perm:[1,1,1,1] row_mask:0xf bank_mask:0xf
    v_add_f32_dpp v160, v142, v160 quad_perm:[2,2,2,2] row_mask:0xf bank_mask:0xf
    v_add_f32_dpp v161, v146, v161 quad_perm:[2,2,2,2] row_mask:0xf bank_mask:0xf
    v_add_f32_dpp v162, v150, v162 quad_perm:[2,2,2,2] row_mask:0xf bank_mask:0xf
    v_add_f32_dpp v163, v154, v163 quad_perm:[2,2,2,2] row_mask:0xf bank_mask:0xf
    v_add_f32_dpp v160, v143, v160 quad_perm:[3,3,3,3] row_mask:0xf bank_mask:0xf
    v_add_f32_dpp v161, v147, v161 quad_perm:[3,3,3,3] row_mask:0xf bank_mask:0xf
    v_add_f32_dpp v162, v151, v162 quad_perm:[3,3,3,3] row_mask:0xf bank_mask:0xf
    v_add_f32_dpp v163, v155, v163 quad_perm:[3,3,3,3] row_mask:0xf bank_mask:0xf
    v_cndmask_b32 v164, v156, v157, s[48:49]
    v_cndmask_b32 v165, v160, v161, s[48:49]
    v_cndmask_b32 v164, v164, v158, s[50:51]
    v_cndmask_b32 v165, v165, v162, s[50:51]
    v_cndmask_b32 v164, v164, v159, s[52:53]
    v_cndmask_b32 v165, v165, v163, s[52:53]
    v_max_f32 v10, v164, v165
    s_nop 1
    v_max_f32_dpp v10, v10, v10 quad_perm:[1,0,3,2] row_mask:0xf bank_mask:0xf
    s_nop 1
    v_max_f32_dpp v10, v10, v10 quad_perm:[2,3,0,1] row_mask:0xf bank_mask:0xf
    s_nop 0
    v_mov_b32 v11, v10
    s_nop 1
    v_permlane16_swap_b32 v10, v11
    s_nop 1
    v_max_f32 v10, v10, v11
    v_mov_b32 v11, v10
    s_nop 1
    v_permlane32_swap_b32 v10, v11
    s_nop 1
    v_max_f32 v10, v10, v11
    v_bfe_u32 v12, v0, 2, 2
    v_lshlrev_b32 v12, 5, v12
    s_lshl_b32 s41, s3, 2
    v_add_u32 v13, s41, v12
    s_mov_b64 exec, 0x1111
    ds_write_b32 v13, v10 offset:35840
    s_mov_b64 exec, -1
    v_mul_f32 v14, s59, v10
    v_fma_f32 v164, v164, s59, -v14
    v_fma_f32 v165, v165, s59, -v14
    v_exp_f32 v164, v164
    v_exp_f32 v165, v165
    s_nop 0
    v_add_f32 v10, v164, v165
    v_cvt_pk_bf16_f32 v164, v164, v164
    v_cvt_pk_bf16_f32 v165, v165, v165
    s_nop 0
    v_and_b32_dpp v124, v164, v166 quad_perm:[0,0,0,0] row_mask:0xf bank_mask:0xf
    v_and_b32_dpp v125, v164, v167 quad_perm:[0,0,0,0] row_mask:0xf bank_mask:0xf
    v_and_b32_dpp v126, v164, v166 quad_perm:[1,1,1,1] row_mask:0xf bank_mask:0xf
    v_and_b32_dpp v127, v164, v167 quad_perm:[1,1,1,1] row_mask:0xf bank_mask:0xf
    v_and_b32_dpp v128, v164, v166 quad_perm:[2,2,2,2] row_mask:0xf bank_mask:0xf
    v_and_b32_dpp v129, v164, v167 quad_perm:[2,2,2,2] row_mask:0xf bank_mask:0xf
    v_and_b32_dpp v130, v164, v166 quad_perm:[3,3,3,3] row_mask:0xf bank_mask:0xf
    v_and_b32_dpp v131, v164, v167 quad_perm:[3,3,3,3] row_mask:0xf bank_mask:0xf
    v_and_b32_dpp v132, v165, v166 quad_perm:[0,0,0,0] row_mask:0xf bank_mask:0xf
    v_and_b32_dpp v133, v165, v167 quad_perm:[0,0,0,0] row_mask:0xf bank_mask:0xf
    v_and_b32_dpp v134, v165, v166 quad_perm:[1,1,1,1] row_mask:0xf bank_mask:0xf
    v_and_b32_dpp v135, v165, v167 quad_perm:[1,1,1,1] row_mask:0xf bank_mask:0xf
    v_and_b32_dpp v136, v165, v166 quad_perm:[2,2,2,2] row_mask:0xf bank_mask:0xf
    v_and_b32_dpp v137, v165, v167 quad_perm:[2,2,2,2] row_mask:0xf bank_mask:0xf
    v_and_b32_dpp v138, v165, v166 quad_perm:[3,3,3,3] row_mask:0xf bank_mask:0xf
    v_and_b32_dpp v139, v165, v167 quad_perm:[3,3,3,3] row_mask:0xf bank_mask:0xf
    v_mfma_f32_16x16x16_bf16 v[140:143], v[64:65], v[124:125], 0
    v_mfma_f32_16x16x16_bf16 v[144:147], v[66:67], v[124:125], 0
    s_waitcnt vmcnt(6)
    v_mfma_f32_16x16x16_bf16 v[140:143], v[68:69], v[126:127], v[140:143]
    v_mfma_f32_16x16x16_bf16 v[144:147], v[70:71], v[126:127], v[144:147]
    s_nop 1
    v_add_f32_dpp v10, v10, v10 quad_perm:[1,0,3,2] row_mask:0xf bank_mask:0xf
    s_nop 1
    v_add_f32_dpp v10, v10, v10 quad_perm:[2,3,0,1] row_mask:0xf bank_mask:0xf
    s_nop 0
    v_mov_b32 v11, v10
    s_nop 1
    v_permlane16_swap_b32 v10, v11
    s_nop 1
    v_add_f32 v10, v10, v11
    v_mov_b32 v11, v10
    s_nop 1
    v_permlane32_swap_b32 v10, v11
    s_nop 1
    v_add_f32 v10, v10, v11
    s_mov_b64 exec, 0x1111
    ds_write_b32 v13, v10 offset:35968
    s_mov_b64 exec, -1
    v_bfe_u32 v11, v0, 2, 2
    v_mul_u32_u24 v170, 544, v11
    v_lshrrev_b32 v11, 4, v0
    v_lshl_add_u32 v170, v11, 7, v170
    v_and_b32 v11, 3, v0
    v_lshl_add_u32 v170, v11, 3, v170
    s_mul_i32 s41, s3, 2176
    s_add_u32 s41, s41, 16384
    v_add_u32 v170, s41, v170
    s_waitcnt vmcnt(5)
    v_mfma_f32_16x16x16_bf16 v[140:143], v[72:73], v[128:129], v[140:143]
    v_mfma_f32_16x16x16_bf16 v[144:147], v[74:75], v[128:129], v[144:147]
    global_load_dwordx4 v[16:19], v7, s[16:17] offset:-4096 nt
    s_and_b32 s42, s3, 3
    s_mul_i32 s41, s42, 544
    s_add_u32 s41, s41, 16384
    v_lshlrev_b32 v171, 3, v0
    v_add_u32 v171, s41, v171
    s_lshl_b32 s41, s60, 4
    s_add_u32 s41, s41, s6
    s_lshl_b32 s41, s41, 12
    s_lshl_b32 s42, s42, 10
    s_add_u32 s41, s41, s42
    s_add_u32 s41, s41, 1048576
    s_add_u32 s44, s32, s41
    s_addc_u32 s45, s33, 0
    s_lshl_b32 s41, s60, 16
    s_lshl_b32 s42, s38, 9
    s_add_u32 s41, s41, s42
    s_lshl_b32 s42, s3, 6
    s_add_u32 s41, s41, s42
    s_add_u32 s41, s41, 1048576
    s_add_u32 s46, s32, s41
    s_addc_u32 s47, s33, 0
    v_lshrrev_b32 v11, 2, v0
    v_lshlrev_b32 v11, 12, v11
    v_and_b32 v12, 3, v0
    v_lshl_add_u32 v6, v12, 4, v11
    s_waitcnt vmcnt(5)
    v_mfma_f32_16x16x16_bf16 v[140:143], v[76:77], v[130:131], v[140:143]
    v_mfma_f32_16x16x16_bf16 v[144:147], v[78:79], v[130:131], v[144:147]
    global_load_dwordx4 v[20:23], v7, s[16:17] offset:-3840 nt
    s_lshl_b32 s41, s2, 12
    s_add_u32 s41, s41, 2097152
    s_add_u32 s14, s32, s41
    s_addc_u32 s15, s33, 0
    s_and_b32 s41, s2, 1
    s_lshl_b32 s41, s41, 11
    s_lshl_b32 s42, s4, 10
    s_add_u32 s41, s41, s42
    s_bfe_u32 s42, s2, 0x20005
    s_lshl_b32 s42, s42, 8
    s_add_u32 s41, s41, s42
    s_bfe_u32 s42, s2, 0x20001
    s_lshl_b32 s42, s42, 6
    s_add_u32 s41, s41, s42
    s_bfe_u32 s42, s2, 0x20003
    s_lshl_b32 s42, s42, 4
    s_add_u32 s41, s41, s42
    s_add_u32 s8, s28, s41
    s_addc_u32 s9, s29, 0
    s_waitcnt vmcnt(5)
    v_mfma_f32_16x16x16_bf16 v[140:143], v[80:81], v[132:133], v[140:143]
    v_mfma_f32_16x16x16_bf16 v[144:147], v[82:83], v[132:133], v[144:147]
    global_load_dwordx4 v[24:27], v7, s[16:17] offset:0 nt
    s_waitcnt vmcnt(5)
    v_mfma_f32_16x16x16_bf16 v[140:143], v[84:85], v[134:135], v[140:143]
    v_mfma_f32_16x16x16_bf16 v[144:147], v[86:87], v[134:135], v[144:147]
    global_load_dwordx4 v[28:31], v7, s[16:17] offset:256 nt
    s_waitcnt vmcnt(5)
    v_mfma_f32_16x16x16_bf16 v[140:143], v[88:89], v[136:137], v[140:143]
    v_mfma_f32_16x16x16_bf16 v[144:147], v[90:91], v[136:137], v[144:147]
    s_waitcnt vmcnt(4)
    v_mfma_f32_16x16x16_bf16 v[140:143], v[92:93], v[138:139], v[140:143]
    v_mfma_f32_16x16x16_bf16 v[144:147], v[94:95], v[138:139], v[144:147]
    s_nop 7
    ds_write2_b32 v170, v140, v144 offset0:0 offset1:1
    ds_write2_b32 v170, v141, v145 offset0:8 offset1:9
    ds_write2_b32 v170, v142, v146 offset0:16 offset1:17
    ds_write2_b32 v170, v143, v147 offset0:24 offset1:25
    s_waitcnt lgkmcnt(0)
    s_barrier
    s_cmp_lt_u32 s3, 4
    s_cbranch_scc0 L_noopub
    s_lshl_b32 s41, s3, 5
    v_mov_b32 v14, s41
    ds_read_b128 v[148:151], v14 offset:35840
    ds_read_b128 v[152:155], v14 offset:35856
    ds_read_b128 v[156:159], v14 offset:35968
    ds_read_b128 v[160:163], v14 offset:35984
    ds_read_b64 v[124:125], v171 offset:0
    ds_read_b64 v[126:127], v171 offset:2176
    ds_read_b64 v[128:129], v171 offset:4352
    ds_read_b64 v[130:131], v171 offset:6528
    ds_read_b64 v[132:133], v171 offset:8704
    ds_read_b64 v[134:135], v171 offset:10880
    ds_read_b64 v[136:137], v171 offset:13056
    ds_read_b64 v[138:139], v171 offset:15232
    v_mov_b32 v15, s35
    s_waitcnt lgkmcnt(10)
    v_max3_f32 v10, v148, v149, v150
    v_max3_f32 v11, v151, v152, v153
    v_max3_f32 v10, v10, v154, v155
    v_max_f32 v10, v10, v11
    v_mul_f32 v168, s59, v10
    v_fma_f32 v148, v148, s59, -v168
    v_fma_f32 v149, v149, s59, -v168
    v_fma_f32 v150, v150, s59, -v168
    v_fma_f32 v151, v151, s59, -v168
    v_fma_f32 v152, v152, s59, -v168
    v_fma_f32 v153, v153, s59, -v168
    v_fma_f32 v154, v154, s59, -v168
    v_fma_f32 v155, v155, s59, -v168
    v_exp_f32 v148, v148
    v_exp_f32 v149, v149
    v_exp_f32 v150, v150
    v_exp_f32 v151, v151
    v_exp_f32 v152, v152
    v_exp_f32 v153, v153
    v_exp_f32 v154, v154
    v_exp_f32 v155, v155
    s_waitcnt lgkmcnt(8)
    v_mul_f32 v156, v156, v148
    v_mul_f32 v157, v157, v149
    v_fma_f32 v156, v158, v150, v156
    v_fma_f32 v157, v159, v151, v157
    v_fma_f32 v156, v160, v152, v156
    v_fma_f32 v157, v161, v153, v157
    v_fma_f32 v156, v162, v154, v156
    v_fma_f32 v157, v163, v155, v157
    s_waitcnt lgkmcnt(0)
    v_mul_f32 v12, v124, v148
    v_mul_f32 v13, v125, v148
    v_mul_f32 v10, v126, v149
    v_mul_f32 v11, v127, v149
    v_fma_f32 v12, v128, v150, v12
    v_fma_f32 v13, v129, v150, v13
    v_fma_f32 v10, v130, v151, v10
    v_fma_f32 v11, v131, v151, v11
    v_fma_f32 v12, v132, v152, v12
    v_fma_f32 v13, v133, v152, v13
    v_fma_f32 v10, v134, v153, v10
    v_fma_f32 v11, v135, v153, v11
    v_fma_f32 v12, v136, v154, v12
    v_fma_f32 v13, v137, v154, v13
    v_fma_f32 v10, v138, v155, v10
    v_fma_f32 v11, v139, v155, v11
    v_add_f32 v156, v156, v157
    v_add_f32 v12, v12, v10
    v_add_f32 v13, v13, v11
    v_cndmask_b32 v14, v168, v156, s[98:99]
    s_cmp_eq_u32 s62, 1
    s_cbranch_scc1 L_oplain
    global_store_dwordx4 v9, v[12:15], s[44:45] sc1
    s_branch L_noopub
L_oplain:
    global_store_dwordx4 v9, v[12:15], s[44:45]
L_noopub:
    s_barrier
    s_mov_b32 s56, 200000
L_pollo:
    global_load_dwordx4 v[116:119], v6, s[46:47] sc1
    s_waitcnt vmcnt(0)
    s_mov_b64 exec, -1
    v_cmp_ne_u32 vcc, s35, v119
    s_cmp_eq_u64 vcc, 0
    s_cbranch_scc1 L_goto
    s_sub_u32 s56, s56, 1
    s_cmp_eq_u32 s56, 0
    s_cbranch_scc1 L_goto
    s_mov_b64 exec, vcc
    s_branch L_pollo
L_goto:
    v_mov_b32_dpp v10, v118 quad_perm:[0,0,2,2] row_mask:0xf bank_mask:0xf
    v_mov_b32_dpp v11, v118 quad_perm:[1,1,3,3] row_mask:0xf bank_mask:0xf
    s_nop 0
    v_max_f32_dpp v12, v10, v10 row_ror:4 row_mask:0xf bank_mask:0xf
    s_nop 1
    v_max_f32_dpp v12, v12, v12 row_ror:8 row_mask:0xf bank_mask:0xf
    s_nop 0
    v_mov_b32 v13, v12
    s_nop 1
    v_permlane16_swap_b32 v12, v13
    s_nop 1
    v_max_f32 v12, v12, v13
    v_sub_f32 v12, v10, v12
    v_exp_f32 v12, v12
    s_nop 0
    v_mul_f32 v11, v11, v12
    v_mul_f32 v116, v116, v12
    v_mul_f32 v117, v117, v12
    s_nop 0
    v_add_f32_dpp v11, v11, v11 row_ror:4 row_mask:0xf bank_mask:0xf
    v_add_f32_dpp v116, v116, v116 row_ror:4 row_mask:0xf bank_mask:0xf
    v_add_f32_dpp v117, v117, v117 row_ror:4 row_mask:0xf bank_mask:0xf
    v_add_f32_dpp v11, v11, v11 row_ror:8 row_mask:0xf bank_mask:0xf
    v_add_f32_dpp v116, v116, v116 row_ror:8 row_mask:0xf bank_mask:0xf
    v_add_f32_dpp v117, v117, v117 row_ror:8 row_mask:0xf bank_mask:0xf
    v_mov_b32 v13, v11
    v_mov_b32 v14, v116
    v_mov_b32 v15, v117
    v_permlane16_swap_b32 v11, v13
    v_permlane16_swap_b32 v116, v14
    v_permlane16_swap_b32 v117, v15
    s_nop 0
    v_add_f32 v11, v11, v13
    v_add_f32 v116, v116, v14
    v_add_f32 v117, v117, v15
    v_rcp_f32 v11, v11
    s_nop 0
    v_mul_f32 v116, v116, v11
    v_mul_f32 v117, v117, v11
    v_cvt_pk_bf16_f32 v10, v116, v117
    ds_bpermute_b32 v10, v169, v10
    s_lshl_b32 s41, s3, 11
    v_lshlrev_b32 v12, 2, v0
    v_add_u32 v12, s41, v12
    s_waitcnt lgkmcnt(0)
    v_perm_b32 v11, v10, v10, s57
    v_and_b32 v100, v11, v1
    v_and_b32 v101, v11, v2
    v_and_b32 v102, v11, v3
    v_and_b32 v103, v11, v4
    v_perm_b32 v13, v10, v10, s58
    v_and_b32 v104, v13, v1
    v_and_b32 v105, v13, v2
    v_and_b32 v106, v13, v3
    v_and_b32 v107, v13, v4
    s_nop 0
    v_mfma_f32_16x16x32_bf16 v[108:111], v[16:19], v[100:103], 0
    v_mfma_f32_16x16x32_bf16 v[112:115], v[20:23], v[100:103], 0
    v_mfma_f32_16x16x32_bf16 v[108:111], v[24:27], v[104:107], v[108:111]
    v_mfma_f32_16x16x32_bf16 v[112:115], v[28:31], v[104:107], v[112:115]
    s_lshl_b32 s41, s3, 9
    v_lshlrev_b32 v10, 3, v0
    v_add_u32 v10, s41, v10
    s_lshl_b32 s41, s4, 19
    s_lshl_b32 s42, s39, 18
    s_add_u32 s41, s41, s42
    s_lshl_b32 s42, s3, 16
    s_add_u32 s41, s41, s42
    s_lshl_b32 s42, s5, 9
    s_add_u32 s41, s41, s42
    s_lshl_b32 s42, s38, 6
    s_add_u32 s41, s41, s42
    s_add_u32 s41, s41, 2097152
    s_add_u32 s44, s32, s41
    s_addc_u32 s45, s33, 0
    v_lshrrev_b32 v11, 2, v0
    v_lshlrev_b32 v11, 12, v11
    v_and_b32 v13, 3, v0
    v_lshl_add_u32 v11, v13, 4, v11
    ds_write2st64_b32 v12, v108, v109 offset0:0 offset1:1
    ds_write2st64_b32 v12, v110, v111 offset0:2 offset1:3
    ds_write2st64_b32 v12, v112, v113 offset0:4 offset1:5
    ds_write2st64_b32 v12, v114, v115 offset0:6 offset1:7
    s_waitcnt lgkmcnt(0)
    s_barrier
    s_cmp_lt_u32 s3, 4
    s_cbranch_scc0 L_fin
    ds_read_b64 v[124:125], v10 offset:0
    ds_read_b64 v[126:127], v10 offset:2048
    ds_read_b64 v[128:129], v10 offset:4096
    ds_read_b64 v[130:131], v10 offset:6144
    ds_read_b64 v[132:133], v10 offset:8192
    ds_read_b64 v[134:135], v10 offset:10240
    ds_read_b64 v[136:137], v10 offset:12288
    ds_read_b64 v[138:139], v10 offset:14336
    v_mov_b32 v13, s35
    v_mov_b32 v15, s35
    s_waitcnt lgkmcnt(0)
    v_add_f32 v124, v124, v126
    v_add_f32 v125, v125, v127
    v_add_f32 v128, v128, v130
    v_add_f32 v129, v129, v131
    v_add_f32 v132, v132, v134
    v_add_f32 v133, v133, v135
    v_add_f32 v136, v136, v138
    v_add_f32 v137, v137, v139
    v_add_f32 v124, v124, v128
    v_add_f32 v125, v125, v129
    v_add_f32 v132, v132, v136
    v_add_f32 v133, v133, v137
    v_add_f32 v12, v124, v132
    v_add_f32 v14, v125, v133
    global_store_dwordx4 v11, v[12:15], s[44:45] sc1
    s_cmp_eq_u32 s3, 0
    s_cbranch_scc0 L_fin
    s_mov_b32 s56, 200000
    s_waitcnt vmcnt(0)
    s_mov_b64 s[40:41], -1
    s_mov_b64 s[48:49], -1
    s_mov_b64 s[50:51], -1
    s_mov_b64 s[52:53], -1
L_pollf:
    s_mov_b64 exec, s[40:41]
    s_cbranch_execz L_fs0
    global_load_dwordx4 v[16:19], v9, s[14:15] offset:0 sc1
L_fs0:
    s_mov_b64 exec, s[48:49]
    s_cbranch_execz L_fs1
    global_load_dwordx4 v[20:23], v9, s[14:15] offset:1024 sc1
L_fs1:
    s_mov_b64 exec, s[50:51]
    s_cbranch_execz L_fs2
    global_load_dwordx4 v[24:27], v9, s[14:15] offset:2048 sc1
L_fs2:
    s_mov_b64 exec, s[52:53]
    s_cbranch_execz L_fs3
    global_load_dwordx4 v[28:31], v9, s[14:15] offset:3072 sc1
L_fs3:
    s_mov_b64 exec, -1
    s_waitcnt vmcnt(0)
    v_cmp_ne_u32 vcc, s35, v17
    v_cmp_ne_u32 s[40:41], s35, v19
    s_nop 0
    s_or_b64 s[40:41], s[40:41], vcc
    v_cmp_ne_u32 vcc, s35, v21
    v_cmp_ne_u32 s[48:49], s35, v23
    s_nop 0
    s_or_b64 s[48:49], s[48:49], vcc
    v_cmp_ne_u32 vcc, s35, v25
    v_cmp_ne_u32 s[50:51], s35, v27
    s_nop 0
    s_or_b64 s[50:51], s[50:51], vcc
    v_cmp_ne_u32 vcc, s35, v29
    v_cmp_ne_u32 s[52:53], s35, v31
    s_nop 0
    s_or_b64 s[52:53], s[52:53], vcc
    s_or_b64 s[54:55], s[40:41], s[48:49]
    s_or_b64 vcc, s[50:51], s[52:53]
    s_or_b64 vcc, vcc, s[54:55]
    s_cmp_eq_u64 vcc, 0
    s_cbranch_scc1 L_gotf
    s_sub_u32 s56, s56, 1
    s_cmp_lg_u32 s56, 0
    s_cbranch_scc1 L_pollf
L_gotf:
    v_add_f32 v16, v16, v20
    v_add_f32 v18, v18, v22
    v_add_f32 v24, v24, v28
    v_add_f32 v26, v26, v30
    v_add_f32 v16, v16, v24
    v_add_f32 v18, v18, v26
    s_nop 1
    v_add_f32_dpp v16, v16, v16 row_ror:4 row_mask:0xf bank_mask:0xf
    v_add_f32_dpp v18, v18, v18 row_ror:4 row_mask:0xf bank_mask:0xf
    s_nop 1
    v_add_f32_dpp v16, v16, v16 row_ror:8 row_mask:0xf bank_mask:0xf
    v_add_f32_dpp v18, v18, v18 row_ror:8 row_mask:0xf bank_mask:0xf
    s_nop 1
    v_mov_b32 v20, v16
    v_mov_b32 v22, v18
    s_nop 1
    v_permlane16_swap_b32 v16, v20
    v_permlane16_swap_b32 v18, v22
    s_nop 1
    v_add_f32 v16, v16, v20
    v_add_f32 v18, v18, v22
    v_mov_b32 v20, v16
    v_mov_b32 v22, v18
    s_nop 1
    v_permlane32_swap_b32 v16, v20
    v_permlane32_swap_b32 v18, v22
    s_nop 1
    v_add_f32 v16, v16, v20
    v_add_f32 v18, v18, v22
    v_cvt_pk_bf16_f32 v16, v16, v18
    v_lshlrev_b32 v11, 2, v0
    s_mov_b64 exec, 0xf
    global_store_dword v11, v16, s[8:9]
    s_and_b32 s41, s2, 127
    s_cmp_eq_u32 s41, 0
    s_cbranch_scc0 L_fin
    s_lshl_b32 s41, s4, 8
    v_mov_b32 v11, s41
    v_mov_b32 v12, s35
    s_mov_b64 exec, 1
    global_store_dword v11, v12, s[32:33]
L_fin:
L_end:
    s_endpgm
.section .rodata,"a"
.p2align 6
.amdhsa_kernel concat_heads__sliding_block_cached__sliding_block_cached__decode_kernel
  .amdhsa_next_free_vgpr 176
  .amdhsa_next_free_sgpr 100
  .amdhsa_accum_offset 176
  .amdhsa_group_segment_fixed_size 0
  .amdhsa_kernarg_size 104
  .amdhsa_user_sgpr_count 2
  .amdhsa_user_sgpr_kernarg_segment_ptr 1
  .amdhsa_system_sgpr_workgroup_id_x 1
.end_amdhsa_kernel
```
